```python
import torch

def _softmax(x, axis=-1):
    return torch.softmax(x, dim=axis)
def _gelu(x):
    return torch.nn.functional.gelu(x, approximate="tanh")
def _silu(x):
    return torch.nn.functional.silu(x)
def _sigmoid(x):
    return torch.sigmoid(x)
def _layernorm(x, axis=-1, eps=1e-5):
    m = x.mean(dim=axis, keepdim=True)
    v = x.var(dim=axis, keepdim=True, unbiased=False)
    return (x - m) / torch.sqrt(v + eps)
def _scatter_add(tgt, idx, src, axis=0):
    return tgt.clone().index_add_(axis, idx, src)
def _segment_sum(src, seg, n):
    out = torch.zeros((n,) + src.shape[1:], dtype=src.dtype)
    return out.index_add_(0, seg, src)
def _pad(x, pw):
    flat = tuple(v for pair in reversed(pw) for v in pair)
    return torch.nn.functional.pad(x, flat)

kernel_name = 'standalone__rmsnorm__sampling'

def setup_inputs():

    _w = (lambda a: (lambda t: t.to(torch.bfloat16) if t.is_floating_point() else t)(torch.as_tensor(a)))
    B, S, D = 1024, 16, 448
    return {
        "x": _w((lambda *s: torch.randn(*s, dtype=torch.bfloat16) * 0.05)(B, S, D)),
        "g": _w((lambda *s: torch.randn(*s, dtype=torch.bfloat16) * 0.05)(D) + 1.0),
    }

def reference(x, g):
    rms = torch.sqrt((x * x).mean(axis=-1, keepdims=True) + 1e-6)
    return x / rms * g
```

```asm
; @launch grid=(512,1,1) block=(256,1,1) lds=1792
.amdgcn_target "amdgcn-amd-amdhsa--gfx950"
.text
.globl standalone__rmsnorm__sampling_kernel
.p2align 12
.p2align 8
.type standalone__rmsnorm__sampling_kernel,@function
standalone__rmsnorm__sampling_kernel:
    s_load_dwordx8 s[4:11], s[0:1], 0
    s_setprio 3
    s_cmpk_ge_u32 s2, 512
    s_cbranch_scc1 L_end
    v_and_b32 v3, 63, v0
    v_min_u32 v3, 55, v3
    v_lshlrev_b32 v3, 4, v3
    v_and_b32 v2, 7, v0
    v_lshlrev_b32 v2, 4, v2
    v_lshrrev_b32 v1, 3, v0
    s_mul_i32 s3, s2, 28672
    v_mul_u32_u24 v1, 896, v1
    v_add3_u32 v1, v1, v2, s3
    s_waitcnt lgkmcnt(0)
    global_load_dwordx4 v[148:151], v3, s[6:7]
    s_setprio 0
    global_load_dwordx4 v[120:123], v1, s[4:5] offset:0
    global_load_dwordx4 v[124:127], v1, s[4:5] offset:128
    global_load_dwordx4 v[128:131], v1, s[4:5] offset:256
    global_load_dwordx4 v[132:135], v1, s[4:5] offset:384
    global_load_dwordx4 v[136:139], v1, s[4:5] offset:512
    global_load_dwordx4 v[140:143], v1, s[4:5] offset:640
    global_load_dwordx4 v[144:147], v1, s[4:5] offset:768
    s_mov_b32 s12, 0xffff0000
    v_mov_b32 v4, 0
    v_mov_b32 v5, 0
    v_mov_b32 v6, 0x358637bd
    v_lshlrev_b32 v3, 1, v3
    v_lshlrev_b32 v2, 1, v2
    s_waitcnt vmcnt(7)
    v_lshlrev_b32 v152, 16, v148
    v_and_b32 v153, s12, v148
    v_lshlrev_b32 v154, 16, v149
    v_and_b32 v155, s12, v149
    v_lshlrev_b32 v156, 16, v150
    v_and_b32 v157, s12, v150
    v_lshlrev_b32 v158, 16, v151
    v_and_b32 v159, s12, v151
    ds_write_b128 v3, v[152:155]
    ds_write_b128 v3, v[156:159] offset:16
    s_waitcnt lgkmcnt(0)
    ds_read_b128 v[8:11], v2 offset:0
    ds_read_b128 v[12:15], v2 offset:16
    ds_read_b128 v[16:19], v2 offset:256
    ds_read_b128 v[20:23], v2 offset:272
    ds_read_b128 v[24:27], v2 offset:512
    ds_read_b128 v[28:31], v2 offset:528
    ds_read_b128 v[32:35], v2 offset:768
    ds_read_b128 v[36:39], v2 offset:784
    ds_read_b128 v[40:43], v2 offset:1024
    ds_read_b128 v[44:47], v2 offset:1040
    ds_read_b128 v[48:51], v2 offset:1280
    ds_read_b128 v[52:55], v2 offset:1296
    ds_read_b128 v[56:59], v2 offset:1536
    ds_read_b128 v[60:63], v2 offset:1552
    s_waitcnt vmcnt(6)
    v_dot2c_f32_bf16 v4, v120, v120
    v_dot2c_f32_bf16 v5, v121, v121
    v_dot2c_f32_bf16 v4, v122, v122
    v_dot2c_f32_bf16 v5, v123, v123
    v_lshlrev_b32 v64, 16, v120
    v_and_b32 v65, s12, v120
    v_lshlrev_b32 v66, 16, v121
    v_and_b32 v67, s12, v121
    v_lshlrev_b32 v68, 16, v122
    v_and_b32 v69, s12, v122
    v_lshlrev_b32 v70, 16, v123
    v_and_b32 v71, s12, v123
    s_waitcnt lgkmcnt(0)
    v_pk_mul_f32 v[64:65], v[64:65], v[8:9]
    v_pk_mul_f32 v[66:67], v[66:67], v[10:11]
    v_pk_mul_f32 v[68:69], v[68:69], v[12:13]
    v_pk_mul_f32 v[70:71], v[70:71], v[14:15]
    s_waitcnt vmcnt(5)
    v_dot2c_f32_bf16 v4, v124, v124
    v_dot2c_f32_bf16 v5, v125, v125
    v_dot2c_f32_bf16 v4, v126, v126
    v_dot2c_f32_bf16 v5, v127, v127
    v_lshlrev_b32 v72, 16, v124
    v_and_b32 v73, s12, v124
    v_lshlrev_b32 v74, 16, v125
    v_and_b32 v75, s12, v125
    v_lshlrev_b32 v76, 16, v126
    v_and_b32 v77, s12, v126
    v_lshlrev_b32 v78, 16, v127
    v_and_b32 v79, s12, v127
    v_pk_mul_f32 v[72:73], v[72:73], v[16:17]
    v_pk_mul_f32 v[74:75], v[74:75], v[18:19]
    v_pk_mul_f32 v[76:77], v[76:77], v[20:21]
    v_pk_mul_f32 v[78:79], v[78:79], v[22:23]
    s_waitcnt vmcnt(4)
    v_dot2c_f32_bf16 v4, v128, v128
    v_dot2c_f32_bf16 v5, v129, v129
    v_dot2c_f32_bf16 v4, v130, v130
    v_dot2c_f32_bf16 v5, v131, v131
    v_lshlrev_b32 v80, 16, v128
    v_and_b32 v81, s12, v128
    v_lshlrev_b32 v82, 16, v129
    v_and_b32 v83, s12, v129
    v_lshlrev_b32 v84, 16, v130
    v_and_b32 v85, s12, v130
    v_lshlrev_b32 v86, 16, v131
    v_and_b32 v87, s12, v131
    v_pk_mul_f32 v[80:81], v[80:81], v[24:25]
    v_pk_mul_f32 v[82:83], v[82:83], v[26:27]
    v_pk_mul_f32 v[84:85], v[84:85], v[28:29]
    v_pk_mul_f32 v[86:87], v[86:87], v[30:31]
    s_waitcnt vmcnt(3)
    v_dot2c_f32_bf16 v4, v132, v132
    v_dot2c_f32_bf16 v5, v133, v133
    v_dot2c_f32_bf16 v4, v134, v134
    v_dot2c_f32_bf16 v5, v135, v135
    v_lshlrev_b32 v88, 16, v132
    v_and_b32 v89, s12, v132
    v_lshlrev_b32 v90, 16, v133
    v_and_b32 v91, s12, v133
    v_lshlrev_b32 v92, 16, v134
    v_and_b32 v93, s12, v134
    v_lshlrev_b32 v94, 16, v135
    v_and_b32 v95, s12, v135
    v_pk_mul_f32 v[88:89], v[88:89], v[32:33]
    v_pk_mul_f32 v[90:91], v[90:91], v[34:35]
    v_pk_mul_f32 v[92:93], v[92:93], v[36:37]
    v_pk_mul_f32 v[94:95], v[94:95], v[38:39]
    s_waitcnt vmcnt(2)
    v_dot2c_f32_bf16 v4, v136, v136
    v_dot2c_f32_bf16 v5, v137, v137
    v_dot2c_f32_bf16 v4, v138, v138
    v_dot2c_f32_bf16 v5, v139, v139
    v_lshlrev_b32 v96, 16, v136
    v_and_b32 v97, s12, v136
    v_lshlrev_b32 v98, 16, v137
    v_and_b32 v99, s12, v137
    v_lshlrev_b32 v100, 16, v138
    v_and_b32 v101, s12, v138
    v_lshlrev_b32 v102, 16, v139
    v_and_b32 v103, s12, v139
    v_pk_mul_f32 v[96:97], v[96:97], v[40:41]
    v_pk_mul_f32 v[98:99], v[98:99], v[42:43]
    v_pk_mul_f32 v[100:101], v[100:101], v[44:45]
    v_pk_mul_f32 v[102:103], v[102:103], v[46:47]
    s_waitcnt vmcnt(1)
    v_dot2c_f32_bf16 v4, v140, v140
    v_dot2c_f32_bf16 v5, v141, v141
    v_dot2c_f32_bf16 v4, v142, v142
    v_dot2c_f32_bf16 v5, v143, v143
    v_lshlrev_b32 v104, 16, v140
    v_and_b32 v105, s12, v140
    v_lshlrev_b32 v106, 16, v141
    v_and_b32 v107, s12, v141
    v_lshlrev_b32 v108, 16, v142
    v_and_b32 v109, s12, v142
    v_lshlrev_b32 v110, 16, v143
    v_and_b32 v111, s12, v143
    v_pk_mul_f32 v[104:105], v[104:105], v[48:49]
    v_pk_mul_f32 v[106:107], v[106:107], v[50:51]
    v_pk_mul_f32 v[108:109], v[108:109], v[52:53]
    v_pk_mul_f32 v[110:111], v[110:111], v[54:55]
    s_waitcnt vmcnt(0)
    v_dot2c_f32_bf16 v4, v144, v144
    v_dot2c_f32_bf16 v5, v145, v145
    v_dot2c_f32_bf16 v4, v146, v146
    v_dot2c_f32_bf16 v5, v147, v147
    v_lshlrev_b32 v112, 16, v144
    v_and_b32 v113, s12, v144
    v_lshlrev_b32 v114, 16, v145
    v_add_f32 v4, v4, v5
    v_and_b32 v115, s12, v145
    v_lshlrev_b32 v116, 16, v146
    v_add_f32_dpp v4, v4, v4 quad_perm:[1,0,3,2] row_mask:0xf bank_mask:0xf
    v_and_b32 v117, s12, v146
    v_lshlrev_b32 v118, 16, v147
    v_add_f32_dpp v4, v4, v4 quad_perm:[2,3,0,1] row_mask:0xf bank_mask:0xf
    v_and_b32 v119, s12, v147
    v_pk_mul_f32 v[112:113], v[112:113], v[56:57]
    v_add_f32_dpp v4, v4, v4 row_half_mirror row_mask:0xf bank_mask:0xf
    v_fmac_f32 v6, 0x3b124925, v4
    v_rsq_f32 v4, v6
    v_pk_mul_f32 v[114:115], v[114:115], v[58:59]
    v_pk_mul_f32 v[64:65], v[64:65], v[4:5] op_sel_hi:[1,0]
    v_pk_mul_f32 v[66:67], v[66:67], v[4:5] op_sel_hi:[1,0]
    v_pk_mul_f32 v[68:69], v[68:69], v[4:5] op_sel_hi:[1,0]
    v_pk_mul_f32 v[70:71], v[70:71], v[4:5] op_sel_hi:[1,0]
    v_cvt_pk_bf16_f32 v120, v64, v65
    v_cvt_pk_bf16_f32 v121, v66, v67
    v_cvt_pk_bf16_f32 v122, v68, v69
    v_cvt_pk_bf16_f32 v123, v70, v71
    v_pk_mul_f32 v[72:73], v[72:73], v[4:5] op_sel_hi:[1,0]
    v_pk_mul_f32 v[74:75], v[74:75], v[4:5] op_sel_hi:[1,0]
    v_pk_mul_f32 v[76:77], v[76:77], v[4:5] op_sel_hi:[1,0]
    v_pk_mul_f32 v[78:79], v[78:79], v[4:5] op_sel_hi:[1,0]
    v_cvt_pk_bf16_f32 v124, v72, v73
    v_cvt_pk_bf16_f32 v125, v74, v75
    v_cvt_pk_bf16_f32 v126, v76, v77
    v_cvt_pk_bf16_f32 v127, v78, v79
    v_pk_mul_f32 v[80:81], v[80:81], v[4:5] op_sel_hi:[1,0]
    v_pk_mul_f32 v[82:83], v[82:83], v[4:5] op_sel_hi:[1,0]
    v_pk_mul_f32 v[84:85], v[84:85], v[4:5] op_sel_hi:[1,0]
    v_pk_mul_f32 v[86:87], v[86:87], v[4:5] op_sel_hi:[1,0]
    v_cvt_pk_bf16_f32 v128, v80, v81
    v_cvt_pk_bf16_f32 v129, v82, v83
    v_cvt_pk_bf16_f32 v130, v84, v85
    v_cvt_pk_bf16_f32 v131, v86, v87
    v_pk_mul_f32 v[88:89], v[88:89], v[4:5] op_sel_hi:[1,0]
    v_pk_mul_f32 v[90:91], v[90:91], v[4:5] op_sel_hi:[1,0]
    v_pk_mul_f32 v[92:93], v[92:93], v[4:5] op_sel_hi:[1,0]
    v_pk_mul_f32 v[94:95], v[94:95], v[4:5] op_sel_hi:[1,0]
    v_cvt_pk_bf16_f32 v132, v88, v89
    v_cvt_pk_bf16_f32 v133, v90, v91
    v_cvt_pk_bf16_f32 v134, v92, v93
    v_cvt_pk_bf16_f32 v135, v94, v95
    v_pk_mul_f32 v[96:97], v[96:97], v[4:5] op_sel_hi:[1,0]
    v_pk_mul_f32 v[98:99], v[98:99], v[4:5] op_sel_hi:[1,0]
    v_pk_mul_f32 v[100:101], v[100:101], v[4:5] op_sel_hi:[1,0]
    v_pk_mul_f32 v[102:103], v[102:103], v[4:5] op_sel_hi:[1,0]
    v_cvt_pk_bf16_f32 v136, v96, v97
    v_cvt_pk_bf16_f32 v137, v98, v99
    v_cvt_pk_bf16_f32 v138, v100, v101
    v_cvt_pk_bf16_f32 v139, v102, v103
    v_pk_mul_f32 v[104:105], v[104:105], v[4:5] op_sel_hi:[1,0]
    v_pk_mul_f32 v[106:107], v[106:107], v[4:5] op_sel_hi:[1,0]
    v_pk_mul_f32 v[108:109], v[108:109], v[4:5] op_sel_hi:[1,0]
    v_pk_mul_f32 v[110:111], v[110:111], v[4:5] op_sel_hi:[1,0]
    v_cvt_pk_bf16_f32 v140, v104, v105
    v_cvt_pk_bf16_f32 v141, v106, v107
    v_cvt_pk_bf16_f32 v142, v108, v109
    v_cvt_pk_bf16_f32 v143, v110, v111
    v_pk_mul_f32 v[116:117], v[116:117], v[60:61]
    v_pk_mul_f32 v[118:119], v[118:119], v[62:63]
    v_pk_mul_f32 v[112:113], v[112:113], v[4:5] op_sel_hi:[1,0]
    v_pk_mul_f32 v[114:115], v[114:115], v[4:5] op_sel_hi:[1,0]
    v_pk_mul_f32 v[116:117], v[116:117], v[4:5] op_sel_hi:[1,0]
    v_pk_mul_f32 v[118:119], v[118:119], v[4:5] op_sel_hi:[1,0]
    v_cvt_pk_bf16_f32 v144, v112, v113
    v_cvt_pk_bf16_f32 v145, v114, v115
    v_cvt_pk_bf16_f32 v146, v116, v117
    v_cvt_pk_bf16_f32 v147, v118, v119
    global_store_dwordx4 v1, v[120:123], s[8:9] offset:0 nt
    global_store_dwordx4 v1, v[124:127], s[8:9] offset:128 nt
    global_store_dwordx4 v1, v[128:131], s[8:9] offset:256 nt
    global_store_dwordx4 v1, v[132:135], s[8:9] offset:384 nt
    global_store_dwordx4 v1, v[136:139], s[8:9] offset:512 nt
    global_store_dwordx4 v1, v[140:143], s[8:9] offset:640 nt
    global_store_dwordx4 v1, v[144:147], s[8:9] offset:768 nt
L_end:
    s_endpgm
.section .rodata,"a"
.p2align 6
.amdhsa_kernel standalone__rmsnorm__sampling_kernel
  .amdhsa_next_free_vgpr 160
  .amdhsa_next_free_sgpr 16
  .amdhsa_accum_offset 160
  .amdhsa_group_segment_fixed_size 0
  .amdhsa_kernarg_size 40
  .amdhsa_user_sgpr_count 2
  .amdhsa_user_sgpr_kernarg_segment_ptr 1
  .amdhsa_system_sgpr_workgroup_id_x 1
  .amdhsa_float_denorm_mode_32 3
.end_amdhsa_kernel
```
